```python
import torch

def _softmax(x, axis=-1):
    return torch.softmax(x, dim=axis)
def _gelu(x):
    return torch.nn.functional.gelu(x, approximate="tanh")
def _silu(x):
    return torch.nn.functional.silu(x)
def _sigmoid(x):
    return torch.sigmoid(x)
def _layernorm(x, axis=-1, eps=1e-5):
    m = x.mean(dim=axis, keepdim=True)
    v = x.var(dim=axis, keepdim=True, unbiased=False)
    return (x - m) / torch.sqrt(v + eps)
def _scatter_add(tgt, idx, src, axis=0):
    return tgt.clone().index_add_(axis, idx, src)
def _segment_sum(src, seg, n):
    out = torch.zeros((n,) + src.shape[1:], dtype=src.dtype)
    return out.index_add_(0, seg, src)
def _pad(x, pw):
    flat = tuple(v for pair in reversed(pw) for v in pair)
    return torch.nn.functional.pad(x, flat)

kernel_name = 'standalone__mha_softmax__sampling'

def setup_inputs():

    _w = (lambda a: (lambda t: t.to(torch.bfloat16) if t.is_floating_point() else t)(torch.as_tensor(a)))
    B, H, Sq, Sk, D = 32, 32, 1, 2048, 128
    return {
        "q": _w((lambda *s: torch.randn(*s, dtype=torch.bfloat16) * 0.8)(B, H, Sq, D)),
        "k": _w((lambda *s: torch.randn(*s, dtype=torch.bfloat16) * 0.8)(B, H, Sk, D)),
        "v": _w((lambda *s: torch.randn(*s, dtype=torch.bfloat16) * 0.05)(B, H, Sk, D)),
    }

def reference(q, k, v):
    scale = q.shape[-1] ** -0.5
    scores = torch.einsum("bhqd,bhkd->bhqk", q, k) * scale
    p = _softmax(scores, axis=-1)
    return torch.einsum("bhqk,bhkd->bhqd", p, v)
```

```asm
; @launch grid=(256,1,1) block=(256,1,1) lds=83968
.amdgcn_target "amdgcn-amd-amdhsa--gfx950"
.text
.globl standalone__mha_softmax__sampling_kernel
.p2align 8
.type standalone__mha_softmax__sampling_kernel,@function
standalone__mha_softmax__sampling_kernel:
    s_cmp_ge_u32 s2, 256
    s_cbranch_scc1 L_end
    s_load_dwordx8 s[4:11], s[0:1], 0
    v_and_b32 v2, 15, v0
    v_lshlrev_b32 v30, 4, v2
    v_mov_b32 v1, v30
    v_bfe_u32 v7, v0, 4, 1
    v_lshl_or_b32 v1, v7, 8, v1
    v_bfe_u32 v7, v0, 5, 1
    v_lshl_or_b32 v1, v7, 9, v1
    v_bfe_u32 v7, v0, 6, 1
    v_lshl_or_b32 v1, v7, 10, v1
    v_bfe_u32 v7, v0, 7, 1
    v_lshl_or_b32 v1, v7, 11, v1
    s_lshl_b32 s12, s2, 21
    s_add_u32 s13, s12, 524288
    s_add_u32 s14, s12, 1048576
    s_add_u32 s15, s12, 1572864
    s_mov_b32 s44, 0x3e0293ee
    s_mov_b32 s19, 0x00020000
    s_mov_b32 s23, 0x00020000
    s_mov_b32 s27, 0x00020000
    s_mov_b32 s31, 0x00020000
    s_mov_b32 s35, 0x00020000
    s_mov_b32 s18, 0x20000000
    s_mov_b32 s22, 0x20000000
    s_mov_b32 s26, 0x20000000
    s_mov_b32 s30, 0x40000
    s_mov_b32 s34, 0x40000
    s_mov_b32 s40, s12
    s_mov_b32 s41, 0
    s_waitcnt lgkmcnt(0)
    s_mov_b32 s28, s4
    s_mov_b32 s29, s5
    s_mov_b32 s24, s6
    s_mov_b32 s25, s7
    s_mov_b32 s20, s8
    s_mov_b32 s21, s9
    s_mov_b32 s32, s10
    s_mov_b32 s33, s11
    s_lshr_b32 s46, s12, 11
    buffer_load_dwordx4 v[44:47], v30, s[28:31], s46 offen
    s_lshr_b32 s46, s13, 11
    buffer_load_dwordx4 v[48:51], v30, s[28:31], s46 offen
    s_lshr_b32 s46, s14, 11
    buffer_load_dwordx4 v[52:55], v30, s[28:31], s46 offen
    s_lshr_b32 s46, s15, 11
    buffer_load_dwordx4 v[56:59], v30, s[28:31], s46 offen
    s_mov_b32 s54, 32
    s_add_u32 s49, s40, 4096
    s_add_u32 s50, s40, 8192
    s_add_u32 s51, s40, 12288
    buffer_load_dwordx4 v[60:63], v1, s[24:27], s40 offen nt
    buffer_load_dwordx4 v[64:67], v1, s[24:27], s49 offen nt
    buffer_load_dwordx4 v[68:71], v1, s[24:27], s50 offen nt
    buffer_load_dwordx4 v[72:75], v1, s[24:27], s51 offen nt
    s_add_u32 s40, s40, 16384
    s_sub_u32 s54, s54, 1
    s_cmp_lg_u32 s54, 0
    s_cbranch_scc1 L_nosw1
    s_mov_b32 s54, 32
    s_add_u32 s41, s41, 1
    s_mov_b32 s46, s12
    s_mov_b32 s12, s13
    s_mov_b32 s13, s14
    s_mov_b32 s14, s15
    s_mov_b32 s15, s46
    s_mov_b32 s40, s12
    s_cmp_lt_u32 s41, 4
    s_cbranch_scc1 L_nosw1
    s_mov_b32 s24, s20
    s_mov_b32 s25, s21
    s_cmp_lt_u32 s41, 8
    s_cselect_b32 s26, s22, 0
L_nosw1:
    s_add_u32 s49, s40, 4096
    s_add_u32 s50, s40, 8192
    s_add_u32 s51, s40, 12288
    buffer_load_dwordx4 v[76:79], v1, s[24:27], s40 offen nt
    v_lshrrev_b32 v7, 6, v0
    v_mul_u32_u24 v7, 8192, v7
    v_bfe_u32 v8, v0, 4, 2
    v_lshl_add_u32 v4, v8, 4, v7
    v_bfe_u32 v8, v0, 2, 1
    v_lshl_add_u32 v3, v8, 3, v4
    v_bfe_u32 v8, v0, 3, 1
    v_lshl_add_u32 v3, v8, 2, v3
    v_lshlrev_b32 v5, 5, v0
    v_add_u32 v5, 33280, v5
    v_mov_b32 v6, 0xff800000
    v_mov_b32 v10, 0
    v_mov_b32 v11, 0
    v_mov_b32 v12, 0
    v_mov_b32 v13, 0
    v_mov_b32 v14, 0
    v_mov_b32 v15, 0
    v_mov_b32 v16, 0
    v_mov_b32 v17, 0
    s_mov_b32 s43, 4
L_khead:
    s_mov_b32 s42, 16
    .p2align 3
L_kloop:
    s_waitcnt vmcnt(4)
    buffer_load_dwordx4 v[80:83], v1, s[24:27], s49 offen nt
    v_dot2_f32_bf16 v18, v60, v44, 0
    v_dot2_f32_bf16 v18, v61, v45, v18
    v_dot2_f32_bf16 v18, v62, v46, v18
    v_dot2_f32_bf16 v18, v63, v47, v18
    s_waitcnt vmcnt(4)
    buffer_load_dwordx4 v[84:87], v1, s[24:27], s50 offen nt
    v_dot2_f32_bf16 v19, v64, v44, 0
    v_dot2_f32_bf16 v19, v65, v45, v19
    v_dot2_f32_bf16 v19, v66, v46, v19
    v_dot2_f32_bf16 v19, v67, v47, v19
    s_waitcnt vmcnt(4)
    buffer_load_dwordx4 v[88:91], v1, s[24:27], s51 offen nt
    s_add_u32 s40, s40, 16384
    s_sub_u32 s54, s54, 1
    s_cmp_lg_u32 s54, 0
    s_cbranch_scc1 L_nosw2
    s_mov_b32 s54, 32
    s_add_u32 s41, s41, 1
    s_mov_b32 s46, s12
    s_mov_b32 s12, s13
    s_mov_b32 s13, s14
    s_mov_b32 s14, s15
    s_mov_b32 s15, s46
    s_mov_b32 s40, s12
    s_cmp_lt_u32 s41, 4
    s_cbranch_scc1 L_nosw2
    s_mov_b32 s24, s20
    s_mov_b32 s25, s21
    s_cmp_lt_u32 s41, 8
    s_cselect_b32 s26, s22, 0
L_nosw2:
    s_add_u32 s49, s40, 4096
    s_add_u32 s50, s40, 8192
    s_add_u32 s51, s40, 12288
    v_dot2_f32_bf16 v20, v68, v44, 0
    v_dot2_f32_bf16 v20, v69, v45, v20
    v_dot2_f32_bf16 v20, v70, v46, v20
    v_dot2_f32_bf16 v20, v71, v47, v20
    s_waitcnt vmcnt(4)
    buffer_load_dwordx4 v[60:63], v1, s[24:27], s40 offen nt
    v_dot2_f32_bf16 v21, v72, v44, 0
    v_dot2_f32_bf16 v21, v73, v45, v21
    v_dot2_f32_bf16 v21, v74, v46, v21
    v_dot2_f32_bf16 v21, v75, v47, v21
    s_nop 2
    v_add_f32_dpp v7, v18, v18 row_ror:8 row_mask:0xf bank_mask:0x3
    v_add_f32_dpp v8, v20, v20 row_ror:8 row_mask:0xf bank_mask:0x3
    v_add_f32_dpp v7, v19, v19 row_ror:8 row_mask:0xf bank_mask:0xc
    v_add_f32_dpp v8, v21, v21 row_ror:8 row_mask:0xf bank_mask:0xc
    s_nop 1
    v_add_f32_dpp v9, v7, v7 row_half_mirror row_mask:0xf bank_mask:0x5
    v_add_f32_dpp v9, v8, v8 row_half_mirror row_mask:0xf bank_mask:0xa
    s_nop 1
    v_add_f32_dpp v9, v9, v9 quad_perm:[1,0,3,2] row_mask:0xf bank_mask:0xf
    s_nop 1
    v_add_f32_dpp v9, v9, v9 quad_perm:[2,3,0,1] row_mask:0xf bank_mask:0xf
    v_max_f32 v6, v6, v9
    ds_write_b32 v3, v9
    s_waitcnt vmcnt(4)
    buffer_load_dwordx4 v[64:67], v1, s[24:27], s49 offen nt
    v_dot2_f32_bf16 v18, v76, v44, 0
    v_dot2_f32_bf16 v18, v77, v45, v18
    v_dot2_f32_bf16 v18, v78, v46, v18
    v_dot2_f32_bf16 v18, v79, v47, v18
    s_waitcnt vmcnt(4)
    buffer_load_dwordx4 v[68:71], v1, s[24:27], s50 offen nt
    v_dot2_f32_bf16 v19, v80, v44, 0
    v_dot2_f32_bf16 v19, v81, v45, v19
    v_dot2_f32_bf16 v19, v82, v46, v19
    v_dot2_f32_bf16 v19, v83, v47, v19
    s_waitcnt vmcnt(4)
    buffer_load_dwordx4 v[72:75], v1, s[24:27], s51 offen nt
    s_add_u32 s40, s40, 16384
    s_sub_u32 s54, s54, 1
    s_cmp_lg_u32 s54, 0
    s_cbranch_scc1 L_nosw3
    s_mov_b32 s54, 32
    s_add_u32 s41, s41, 1
    s_mov_b32 s46, s12
    s_mov_b32 s12, s13
    s_mov_b32 s13, s14
    s_mov_b32 s14, s15
    s_mov_b32 s15, s46
    s_mov_b32 s40, s12
    s_cmp_lt_u32 s41, 4
    s_cbranch_scc1 L_nosw3
    s_mov_b32 s24, s20
    s_mov_b32 s25, s21
    s_cmp_lt_u32 s41, 8
    s_cselect_b32 s26, s22, 0
L_nosw3:
    s_add_u32 s49, s40, 4096
    s_add_u32 s50, s40, 8192
    s_add_u32 s51, s40, 12288
    v_dot2_f32_bf16 v20, v84, v44, 0
    v_dot2_f32_bf16 v20, v85, v45, v20
    v_dot2_f32_bf16 v20, v86, v46, v20
    v_dot2_f32_bf16 v20, v87, v47, v20
    s_waitcnt vmcnt(4)
    buffer_load_dwordx4 v[76:79], v1, s[24:27], s40 offen nt
    v_dot2_f32_bf16 v21, v88, v44, 0
    v_dot2_f32_bf16 v21, v89, v45, v21
    v_dot2_f32_bf16 v21, v90, v46, v21
    v_dot2_f32_bf16 v21, v91, v47, v21
    s_nop 2
    v_add_f32_dpp v7, v18, v18 row_ror:8 row_mask:0xf bank_mask:0x3
    v_add_f32_dpp v8, v20, v20 row_ror:8 row_mask:0xf bank_mask:0x3
    v_add_f32_dpp v7, v19, v19 row_ror:8 row_mask:0xf bank_mask:0xc
    v_add_f32_dpp v8, v21, v21 row_ror:8 row_mask:0xf bank_mask:0xc
    s_nop 1
    v_add_f32_dpp v9, v7, v7 row_half_mirror row_mask:0xf bank_mask:0x5
    v_add_f32_dpp v9, v8, v8 row_half_mirror row_mask:0xf bank_mask:0xa
    s_nop 1
    v_add_f32_dpp v9, v9, v9 quad_perm:[1,0,3,2] row_mask:0xf bank_mask:0xf
    s_nop 1
    v_add_f32_dpp v9, v9, v9 quad_perm:[2,3,0,1] row_mask:0xf bank_mask:0xf
    v_max_f32 v6, v6, v9
    ds_write_b32 v3, v9 offset:64
    v_add_u32 v3, 128, v3
    s_sub_u32 s42, s42, 1
    s_cmp_lg_u32 s42, 0
    s_cbranch_scc1 L_kloop
    v_mov_b32 v38, v39
    v_mov_b32 v39, v40
    v_mov_b32 v40, v41
    v_max_f32_dpp v6, v6, v6 row_ror:4 row_mask:0xf bank_mask:0xf
    s_nop 1
    v_mov_b32 v44, v48
    v_mov_b32 v45, v49
    v_mov_b32 v46, v50
    v_mov_b32 v47, v51
    v_mov_b32 v48, v52
    v_mov_b32 v49, v53
    v_mov_b32 v50, v54
    v_mov_b32 v51, v55
    v_mov_b32 v52, v56
    v_mov_b32 v53, v57
    v_mov_b32 v54, v58
    v_mov_b32 v55, v59
    v_max_f32_dpp v6, v6, v6 row_ror:8 row_mask:0xf bank_mask:0xf
    s_sub_u32 s43, s43, 1
    s_cmp_lg_u32 s43, 0
    v_mul_f32 v41, s44, v6
    v_mov_b32 v6, 0xff800000
    s_cbranch_scc1 L_khead
    buffer_load_dwordx4 v[80:83], v1, s[24:27], s49 offen nt
    v_and_b32 v2, 15, v0
    v_lshl_add_u32 v2, v2, 6, v4
    v_lshrrev_b32 v7, 4, v0
    v_lshlrev_b32 v7, 3, v7
    v_mov_b32 v18, 0
    v_mov_b32 v19, 0
    v_mov_b32 v20, 0
    v_mov_b32 v21, 0
    ds_read_b128 v[22:25], v2 offset:0
    ds_read_b128 v[26:29], v2 offset:1024
    ds_read_b128 v[30:33], v2 offset:2048
    ds_read_b128 v[34:37], v2 offset:3072
    s_waitcnt lgkmcnt(0)
    v_fma_f32 v22, v22, s44, -v38
    v_fma_f32 v23, v23, s44, -v38
    v_fma_f32 v24, v24, s44, -v38
    v_fma_f32 v25, v25, s44, -v38
    v_fma_f32 v26, v26, s44, -v38
    v_fma_f32 v27, v27, s44, -v38
    v_fma_f32 v28, v28, s44, -v38
    v_fma_f32 v29, v29, s44, -v38
    v_fma_f32 v30, v30, s44, -v39
    v_fma_f32 v31, v31, s44, -v39
    v_fma_f32 v32, v32, s44, -v39
    v_fma_f32 v33, v33, s44, -v39
    v_fma_f32 v34, v34, s44, -v39
    v_fma_f32 v35, v35, s44, -v39
    v_fma_f32 v36, v36, s44, -v39
    v_fma_f32 v37, v37, s44, -v39
    v_exp_f32 v22, v22
    v_exp_f32 v23, v23
    v_exp_f32 v24, v24
    v_exp_f32 v25, v25
    v_exp_f32 v26, v26
    v_exp_f32 v27, v27
    v_exp_f32 v28, v28
    v_exp_f32 v29, v29
    v_exp_f32 v30, v30
    v_exp_f32 v31, v31
    v_exp_f32 v32, v32
    v_exp_f32 v33, v33
    v_exp_f32 v34, v34
    v_exp_f32 v35, v35
    v_exp_f32 v36, v36
    v_exp_f32 v37, v37
    s_nop 0
    ds_write_b128 v2, v[22:25] offset:0
    v_add_f32 v18, v18, v22
    v_add_f32 v18, v18, v23
    v_add_f32 v18, v18, v24
    v_add_f32 v18, v18, v25
    ds_write_b128 v2, v[26:29] offset:1024
    v_add_f32 v18, v18, v26
    v_add_f32 v18, v18, v27
    v_add_f32 v18, v18, v28
    v_add_f32 v18, v18, v29
    ds_write_b128 v2, v[30:33] offset:2048
    v_add_f32 v19, v19, v30
    v_add_f32 v19, v19, v31
    v_add_f32 v19, v19, v32
    v_add_f32 v19, v19, v33
    ds_write_b128 v2, v[34:37] offset:3072
    v_add_f32 v19, v19, v34
    v_add_f32 v19, v19, v35
    v_add_f32 v19, v19, v36
    v_add_f32 v19, v19, v37
    s_waitcnt lgkmcnt(0)
    ds_read_b128 v[22:25], v2 offset:4096
    ds_read_b128 v[26:29], v2 offset:5120
    ds_read_b128 v[30:33], v2 offset:6144
    ds_read_b128 v[34:37], v2 offset:7168
    s_waitcnt lgkmcnt(0)
    v_fma_f32 v22, v22, s44, -v40
    v_fma_f32 v23, v23, s44, -v40
    v_fma_f32 v24, v24, s44, -v40
    v_fma_f32 v25, v25, s44, -v40
    v_fma_f32 v26, v26, s44, -v40
    v_fma_f32 v27, v27, s44, -v40
    v_fma_f32 v28, v28, s44, -v40
    v_fma_f32 v29, v29, s44, -v40
    v_fma_f32 v30, v30, s44, -v41
    v_fma_f32 v31, v31, s44, -v41
    v_fma_f32 v32, v32, s44, -v41
    v_fma_f32 v33, v33, s44, -v41
    v_fma_f32 v34, v34, s44, -v41
    v_fma_f32 v35, v35, s44, -v41
    v_fma_f32 v36, v36, s44, -v41
    v_fma_f32 v37, v37, s44, -v41
    v_exp_f32 v22, v22
    v_exp_f32 v23, v23
    v_exp_f32 v24, v24
    v_exp_f32 v25, v25
    v_exp_f32 v26, v26
    v_exp_f32 v27, v27
    v_exp_f32 v28, v28
    v_exp_f32 v29, v29
    v_exp_f32 v30, v30
    v_exp_f32 v31, v31
    v_exp_f32 v32, v32
    v_exp_f32 v33, v33
    v_exp_f32 v34, v34
    v_exp_f32 v35, v35
    v_exp_f32 v36, v36
    v_exp_f32 v37, v37
    s_nop 0
    ds_write_b128 v2, v[22:25] offset:4096
    v_add_f32 v20, v20, v22
    v_add_f32 v20, v20, v23
    v_add_f32 v20, v20, v24
    v_add_f32 v20, v20, v25
    ds_write_b128 v2, v[26:29] offset:5120
    v_add_f32 v20, v20, v26
    v_add_f32 v20, v20, v27
    v_add_f32 v20, v20, v28
    v_add_f32 v20, v20, v29
    ds_write_b128 v2, v[30:33] offset:6144
    v_add_f32 v21, v21, v30
    v_add_f32 v21, v21, v31
    v_add_f32 v21, v21, v32
    v_add_f32 v21, v21, v33
    ds_write_b128 v2, v[34:37] offset:7168
    v_add_f32 v21, v21, v34
    v_add_f32 v21, v21, v35
    v_add_f32 v21, v21, v36
    v_add_f32 v21, v21, v37
    s_waitcnt lgkmcnt(0)
    s_nop 1
    v_add_f32_dpp v18, v18, v18 row_ror:8 row_mask:0xf bank_mask:0xf
    v_add_f32_dpp v19, v19, v19 row_ror:8 row_mask:0xf bank_mask:0xf
    v_add_f32_dpp v20, v20, v20 row_ror:8 row_mask:0xf bank_mask:0xf
    v_add_f32_dpp v21, v21, v21 row_ror:8 row_mask:0xf bank_mask:0xf
    v_add_f32_dpp v18, v18, v18 row_ror:4 row_mask:0xf bank_mask:0xf
    v_add_f32_dpp v19, v19, v19 row_ror:4 row_mask:0xf bank_mask:0xf
    v_add_f32_dpp v20, v20, v20 row_ror:4 row_mask:0xf bank_mask:0xf
    v_add_f32_dpp v21, v21, v21 row_ror:4 row_mask:0xf bank_mask:0xf
    v_add_f32_dpp v18, v18, v18 row_ror:2 row_mask:0xf bank_mask:0xf
    v_add_f32_dpp v19, v19, v19 row_ror:2 row_mask:0xf bank_mask:0xf
    v_add_f32_dpp v20, v20, v20 row_ror:2 row_mask:0xf bank_mask:0xf
    v_add_f32_dpp v21, v21, v21 row_ror:2 row_mask:0xf bank_mask:0xf
    v_add_f32_dpp v18, v18, v18 row_ror:1 row_mask:0xf bank_mask:0xf
    v_add_f32_dpp v19, v19, v19 row_ror:1 row_mask:0xf bank_mask:0xf
    v_add_f32_dpp v20, v20, v20 row_ror:1 row_mask:0xf bank_mask:0xf
    v_add_f32_dpp v21, v21, v21 row_ror:1 row_mask:0xf bank_mask:0xf
    v_mov_b32 v30, v38
    v_mov_b32 v31, v18
    v_mov_b32 v32, v39
    v_mov_b32 v33, v19
    v_mov_b32 v34, v40
    v_mov_b32 v35, v20
    v_mov_b32 v36, v41
    v_mov_b32 v37, v21
    ds_write_b64 v7, v[30:31] offset:32768
    ds_write_b64 v7, v[32:33] offset:32896
    ds_write_b64 v7, v[34:35] offset:33024
    ds_write_b64 v7, v[36:37] offset:33152
    ds_read_b128 v[22:25], v4
    s_mov_b32 s43, 4
L_vhead:
    s_mov_b32 s42, 16
    .p2align 3
L_vloop:
    s_waitcnt vmcnt(5) lgkmcnt(0)
    buffer_load_dwordx4 v[84:87], v1, s[24:27], s50 offen nt
    ds_read_b128 v[26:29], v4 offset:64
    v_lshlrev_b32 v30, 16, v60
    v_and_b32 v31, 0xffff0000, v60
    v_lshlrev_b32 v32, 16, v61
    v_and_b32 v33, 0xffff0000, v61
    v_lshlrev_b32 v34, 16, v62
    v_and_b32 v35, 0xffff0000, v62
    v_lshlrev_b32 v36, 16, v63
    v_and_b32 v37, 0xffff0000, v63
    v_pk_fma_f32 v[10:11], v[30:31], v[22:23], v[10:11] op_sel:[0,0,0] op_sel_hi:[1,0,1]
    v_pk_fma_f32 v[12:13], v[32:33], v[22:23], v[12:13] op_sel:[0,0,0] op_sel_hi:[1,0,1]
    v_pk_fma_f32 v[14:15], v[34:35], v[22:23], v[14:15] op_sel:[0,0,0] op_sel_hi:[1,0,1]
    v_pk_fma_f32 v[16:17], v[36:37], v[22:23], v[16:17] op_sel:[0,0,0] op_sel_hi:[1,0,1]
    s_waitcnt vmcnt(5)
    buffer_load_dwordx4 v[88:91], v1, s[24:27], s51 offen nt
    s_add_u32 s40, s40, 16384
    s_sub_u32 s54, s54, 1
    s_cmp_lg_u32 s54, 0
    s_cbranch_scc1 L_nosw4
    s_mov_b32 s54, 32
    s_add_u32 s41, s41, 1
    s_mov_b32 s46, s12
    s_mov_b32 s12, s13
    s_mov_b32 s13, s14
    s_mov_b32 s14, s15
    s_mov_b32 s15, s46
    s_mov_b32 s40, s12
    s_cmp_lt_u32 s41, 4
    s_cbranch_scc1 L_nosw4
    s_mov_b32 s24, s20
    s_mov_b32 s25, s21
    s_cmp_lt_u32 s41, 8
    s_cselect_b32 s26, s22, 0
L_nosw4:
    s_add_u32 s49, s40, 4096
    s_add_u32 s50, s40, 8192
    s_add_u32 s51, s40, 12288
    v_lshlrev_b32 v30, 16, v64
    v_and_b32 v31, 0xffff0000, v64
    v_lshlrev_b32 v32, 16, v65
    v_and_b32 v33, 0xffff0000, v65
    v_lshlrev_b32 v34, 16, v66
    v_and_b32 v35, 0xffff0000, v66
    v_lshlrev_b32 v36, 16, v67
    v_and_b32 v37, 0xffff0000, v67
    v_pk_fma_f32 v[10:11], v[30:31], v[22:23], v[10:11] op_sel:[0,1,0] op_sel_hi:[1,1,1]
    v_pk_fma_f32 v[12:13], v[32:33], v[22:23], v[12:13] op_sel:[0,1,0] op_sel_hi:[1,1,1]
    v_pk_fma_f32 v[14:15], v[34:35], v[22:23], v[14:15] op_sel:[0,1,0] op_sel_hi:[1,1,1]
    v_pk_fma_f32 v[16:17], v[36:37], v[22:23], v[16:17] op_sel:[0,1,0] op_sel_hi:[1,1,1]
    s_waitcnt vmcnt(5)
    buffer_load_dwordx4 v[60:63], v1, s[24:27], s40 offen nt
    v_lshlrev_b32 v30, 16, v68
    v_and_b32 v31, 0xffff0000, v68
    v_lshlrev_b32 v32, 16, v69
    v_and_b32 v33, 0xffff0000, v69
    v_lshlrev_b32 v34, 16, v70
    v_and_b32 v35, 0xffff0000, v70
    v_lshlrev_b32 v36, 16, v71
    v_and_b32 v37, 0xffff0000, v71
    v_pk_fma_f32 v[10:11], v[30:31], v[24:25], v[10:11] op_sel:[0,0,0] op_sel_hi:[1,0,1]
    v_pk_fma_f32 v[12:13], v[32:33], v[24:25], v[12:13] op_sel:[0,0,0] op_sel_hi:[1,0,1]
    v_pk_fma_f32 v[14:15], v[34:35], v[24:25], v[14:15] op_sel:[0,0,0] op_sel_hi:[1,0,1]
    v_pk_fma_f32 v[16:17], v[36:37], v[24:25], v[16:17] op_sel:[0,0,0] op_sel_hi:[1,0,1]
    s_waitcnt vmcnt(5)
    buffer_load_dwordx4 v[64:67], v1, s[24:27], s49 offen nt
    v_lshlrev_b32 v30, 16, v72
    v_and_b32 v31, 0xffff0000, v72
    v_lshlrev_b32 v32, 16, v73
    v_and_b32 v33, 0xffff0000, v73
    v_lshlrev_b32 v34, 16, v74
    v_and_b32 v35, 0xffff0000, v74
    v_lshlrev_b32 v36, 16, v75
    v_and_b32 v37, 0xffff0000, v75
    v_pk_fma_f32 v[10:11], v[30:31], v[24:25], v[10:11] op_sel:[0,1,0] op_sel_hi:[1,1,1]
    v_pk_fma_f32 v[12:13], v[32:33], v[24:25], v[12:13] op_sel:[0,1,0] op_sel_hi:[1,1,1]
    v_pk_fma_f32 v[14:15], v[34:35], v[24:25], v[14:15] op_sel:[0,1,0] op_sel_hi:[1,1,1]
    v_pk_fma_f32 v[16:17], v[36:37], v[24:25], v[16:17] op_sel:[0,1,0] op_sel_hi:[1,1,1]
    s_waitcnt vmcnt(5) lgkmcnt(0)
    buffer_load_dwordx4 v[68:71], v1, s[24:27], s50 offen nt
    ds_read_b128 v[22:25], v4 offset:128
    v_lshlrev_b32 v30, 16, v76
    v_and_b32 v31, 0xffff0000, v76
    v_lshlrev_b32 v32, 16, v77
    v_and_b32 v33, 0xffff0000, v77
    v_lshlrev_b32 v34, 16, v78
    v_and_b32 v35, 0xffff0000, v78
    v_lshlrev_b32 v36, 16, v79
    v_and_b32 v37, 0xffff0000, v79
    v_pk_fma_f32 v[10:11], v[30:31], v[26:27], v[10:11] op_sel:[0,0,0] op_sel_hi:[1,0,1]
    v_pk_fma_f32 v[12:13], v[32:33], v[26:27], v[12:13] op_sel:[0,0,0] op_sel_hi:[1,0,1]
    v_pk_fma_f32 v[14:15], v[34:35], v[26:27], v[14:15] op_sel:[0,0,0] op_sel_hi:[1,0,1]
    v_pk_fma_f32 v[16:17], v[36:37], v[26:27], v[16:17] op_sel:[0,0,0] op_sel_hi:[1,0,1]
    s_waitcnt vmcnt(5)
    buffer_load_dwordx4 v[72:75], v1, s[24:27], s51 offen nt
    s_add_u32 s40, s40, 16384
    s_sub_u32 s54, s54, 1
    s_cmp_lg_u32 s54, 0
    s_cbranch_scc1 L_nosw5
    s_mov_b32 s54, 32
    s_add_u32 s41, s41, 1
    s_mov_b32 s46, s12
    s_mov_b32 s12, s13
    s_mov_b32 s13, s14
    s_mov_b32 s14, s15
    s_mov_b32 s15, s46
    s_mov_b32 s40, s12
    s_cmp_lt_u32 s41, 4
    s_cbranch_scc1 L_nosw5
    s_mov_b32 s24, s20
    s_mov_b32 s25, s21
    s_cmp_lt_u32 s41, 8
    s_cselect_b32 s26, s22, 0
L_nosw5:
    s_add_u32 s49, s40, 4096
    s_add_u32 s50, s40, 8192
    s_add_u32 s51, s40, 12288
    v_lshlrev_b32 v30, 16, v80
    v_and_b32 v31, 0xffff0000, v80
    v_lshlrev_b32 v32, 16, v81
    v_and_b32 v33, 0xffff0000, v81
    v_lshlrev_b32 v34, 16, v82
    v_and_b32 v35, 0xffff0000, v82
    v_lshlrev_b32 v36, 16, v83
    v_and_b32 v37, 0xffff0000, v83
    v_pk_fma_f32 v[10:11], v[30:31], v[26:27], v[10:11] op_sel:[0,1,0] op_sel_hi:[1,1,1]
    v_pk_fma_f32 v[12:13], v[32:33], v[26:27], v[12:13] op_sel:[0,1,0] op_sel_hi:[1,1,1]
    v_pk_fma_f32 v[14:15], v[34:35], v[26:27], v[14:15] op_sel:[0,1,0] op_sel_hi:[1,1,1]
    v_pk_fma_f32 v[16:17], v[36:37], v[26:27], v[16:17] op_sel:[0,1,0] op_sel_hi:[1,1,1]
    s_waitcnt vmcnt(5)
    buffer_load_dwordx4 v[76:79], v1, s[24:27], s40 offen nt
    v_lshlrev_b32 v30, 16, v84
    v_and_b32 v31, 0xffff0000, v84
    v_lshlrev_b32 v32, 16, v85
    v_and_b32 v33, 0xffff0000, v85
    v_lshlrev_b32 v34, 16, v86
    v_and_b32 v35, 0xffff0000, v86
    v_lshlrev_b32 v36, 16, v87
    v_and_b32 v37, 0xffff0000, v87
    v_pk_fma_f32 v[10:11], v[30:31], v[28:29], v[10:11] op_sel:[0,0,0] op_sel_hi:[1,0,1]
    v_pk_fma_f32 v[12:13], v[32:33], v[28:29], v[12:13] op_sel:[0,0,0] op_sel_hi:[1,0,1]
    v_pk_fma_f32 v[14:15], v[34:35], v[28:29], v[14:15] op_sel:[0,0,0] op_sel_hi:[1,0,1]
    v_pk_fma_f32 v[16:17], v[36:37], v[28:29], v[16:17] op_sel:[0,0,0] op_sel_hi:[1,0,1]
    s_waitcnt vmcnt(5)
    buffer_load_dwordx4 v[80:83], v1, s[24:27], s49 offen nt
    v_lshlrev_b32 v30, 16, v88
    v_and_b32 v31, 0xffff0000, v88
    v_lshlrev_b32 v32, 16, v89
    v_and_b32 v33, 0xffff0000, v89
    v_lshlrev_b32 v34, 16, v90
    v_and_b32 v35, 0xffff0000, v90
    v_lshlrev_b32 v36, 16, v91
    v_and_b32 v37, 0xffff0000, v91
    v_pk_fma_f32 v[10:11], v[30:31], v[28:29], v[10:11] op_sel:[0,1,0] op_sel_hi:[1,1,1]
    v_pk_fma_f32 v[12:13], v[32:33], v[28:29], v[12:13] op_sel:[0,1,0] op_sel_hi:[1,1,1]
    v_pk_fma_f32 v[14:15], v[34:35], v[28:29], v[14:15] op_sel:[0,1,0] op_sel_hi:[1,1,1]
    v_pk_fma_f32 v[16:17], v[36:37], v[28:29], v[16:17] op_sel:[0,1,0] op_sel_hi:[1,1,1]
    v_add_u32 v4, 128, v4
    s_sub_u32 s42, s42, 1
    s_cmp_lg_u32 s42, 0
    s_cbranch_scc1 L_vloop
    ds_write_b128 v5, v[10:13]
    ds_write_b128 v5, v[14:17] offset:16
    s_sub_u32 s43, s43, 1
    s_cmp_lg_u32 s43, 0
    v_add_u32 v5, 8192, v5
    s_waitcnt lgkmcnt(0)
    v_mov_b32 v10, 0
    v_mov_b32 v11, 0
    v_mov_b32 v12, 0
    v_mov_b32 v13, 0
    v_mov_b32 v14, 0
    v_mov_b32 v15, 0
    v_mov_b32 v16, 0
    v_mov_b32 v17, 0
    s_cbranch_scc1 L_vhead
    s_waitcnt vmcnt(0)
    s_barrier
    v_cmp_gt_u32 vcc, 256, v0
    s_and_saveexec_b64 s[88:89], vcc
    s_cbranch_execz L_end
    v_lshrrev_b32 v7, 6, v0
    v_and_b32 v8, 63, v0
    v_and_b32 v31, 15, v0
    v_lshlrev_b32 v31, 3, v31
    v_mul_u32_u24 v2, 128, v7
    v_add_u32 v31, v31, v2
    ds_read_b64 v[22:23], v31 offset:32768
    v_mul_u32_u24 v2, 8192, v7
    v_lshl_add_u32 v30, v8, 3, v2
    v_add_u32 v30, 33280, v30
    ds_read_b64 v[60:61], v30 offset:0
    ds_read_b64 v[62:63], v30 offset:512
    ds_read_b64 v[64:65], v30 offset:1024
    ds_read_b64 v[66:67], v30 offset:1536
    ds_read_b64 v[68:69], v30 offset:2048
    ds_read_b64 v[70:71], v30 offset:2560
    ds_read_b64 v[72:73], v30 offset:3072
    ds_read_b64 v[74:75], v30 offset:3584
    s_waitcnt lgkmcnt(4)
    ds_read_b64 v[76:77], v30 offset:4096
    ds_read_b64 v[78:79], v30 offset:4608
    ds_read_b64 v[80:81], v30 offset:5120
    ds_read_b64 v[82:83], v30 offset:5632
    ds_read_b64 v[84:85], v30 offset:6144
    ds_read_b64 v[86:87], v30 offset:6656
    ds_read_b64 v[88:89], v30 offset:7168
    ds_read_b64 v[90:91], v30 offset:7680
    s_waitcnt lgkmcnt(4)
    v_readfirstlane_b32 s47, v7
    s_waitcnt lgkmcnt(0)
    v_mov_b32 v24, v22
    s_nop 1
    v_max_f32_dpp v24, v24, v24 row_ror:1 row_mask:0xf bank_mask:0xf
    s_nop 1
    v_max_f32_dpp v24, v24, v24 row_ror:2 row_mask:0xf bank_mask:0xf
    s_nop 1
    v_max_f32_dpp v24, v24, v24 row_ror:4 row_mask:0xf bank_mask:0xf
    s_nop 1
    v_max_f32_dpp v24, v24, v24 row_ror:8 row_mask:0xf bank_mask:0xf
    s_nop 1
    v_sub_f32 v22, v22, v24
    v_exp_f32 v22, v22
    s_nop 1
    v_mul_f32 v23, v23, v22
    s_nop 1
    v_add_f32_dpp v23, v23, v23 row_ror:1 row_mask:0xf bank_mask:0xf
    s_nop 1
    v_add_f32_dpp v23, v23, v23 row_ror:2 row_mask:0xf bank_mask:0xf
    s_nop 1
    v_add_f32_dpp v23, v23, v23 row_ror:4 row_mask:0xf bank_mask:0xf
    s_nop 1
    v_add_f32_dpp v23, v23, v23 row_ror:8 row_mask:0xf bank_mask:0xf
    s_nop 1
    v_rcp_f32 v23, v23
    s_nop 1
    v_mul_f32 v22, v22, v23
    s_nop 1
    v_readlane_b32 s56, v22, 0
    v_readlane_b32 s57, v22, 1
    v_readlane_b32 s58, v22, 2
    v_readlane_b32 s59, v22, 3
    v_readlane_b32 s60, v22, 4
    v_readlane_b32 s61, v22, 5
    v_readlane_b32 s62, v22, 6
    v_readlane_b32 s63, v22, 7
    v_readlane_b32 s64, v22, 8
    v_readlane_b32 s65, v22, 9
    v_readlane_b32 s66, v22, 10
    v_readlane_b32 s67, v22, 11
    v_readlane_b32 s68, v22, 12
    v_readlane_b32 s69, v22, 13
    v_readlane_b32 s70, v22, 14
    v_readlane_b32 s71, v22, 15
    v_mov_b32 v10, 0
    v_mov_b32 v11, 0
    s_mov_b32 s46, s12
    s_cmp_eq_u32 s47, 1
    s_cselect_b32 s46, s13, s46
    s_cmp_eq_u32 s47, 2
    s_cselect_b32 s46, s14, s46
    s_cmp_eq_u32 s47, 3
    s_cselect_b32 s46, s15, s46
    s_lshr_b32 s47, s46, 11
    v_fmac_f32 v10, s56, v60
    v_fmac_f32 v11, s56, v61
    v_fmac_f32 v10, s57, v62
    v_fmac_f32 v11, s57, v63
    v_fmac_f32 v10, s58, v64
    v_fmac_f32 v11, s58, v65
    v_fmac_f32 v10, s59, v66
    v_fmac_f32 v11, s59, v67
    v_fmac_f32 v10, s60, v68
    v_fmac_f32 v11, s60, v69
    v_fmac_f32 v10, s61, v70
    v_fmac_f32 v11, s61, v71
    v_fmac_f32 v10, s62, v72
    v_fmac_f32 v11, s62, v73
    v_fmac_f32 v10, s63, v74
    v_fmac_f32 v11, s63, v75
    v_fmac_f32 v10, s64, v76
    v_fmac_f32 v11, s64, v77
    v_fmac_f32 v10, s65, v78
    v_fmac_f32 v11, s65, v79
    v_fmac_f32 v10, s66, v80
    v_fmac_f32 v11, s66, v81
    v_fmac_f32 v10, s67, v82
    v_fmac_f32 v11, s67, v83
    v_fmac_f32 v10, s68, v84
    v_fmac_f32 v11, s68, v85
    v_fmac_f32 v10, s69, v86
    v_fmac_f32 v11, s69, v87
    v_fmac_f32 v10, s70, v88
    v_fmac_f32 v11, s70, v89
    v_fmac_f32 v10, s71, v90
    v_fmac_f32 v11, s71, v91
    v_cvt_pk_bf16_f32 v10, v10, v11
    v_lshlrev_b32 v8, 2, v8
    buffer_store_dword v10, v8, s[32:35], s47 offen
L_end:
    s_endpgm
.section .rodata,"a"
.p2align 6
.amdhsa_kernel standalone__mha_softmax__sampling_kernel
  .amdhsa_next_free_vgpr 92
  .amdhsa_next_free_sgpr 90
  .amdhsa_accum_offset 92
  .amdhsa_group_segment_fixed_size 0
  .amdhsa_kernarg_size 48
  .amdhsa_user_sgpr_count 2
  .amdhsa_user_sgpr_kernarg_segment_ptr 1
  .amdhsa_system_sgpr_workgroup_id_x 1
.end_amdhsa_kernel
```
